```python
import torch

def _softmax(x, axis=-1):
    return torch.softmax(x, dim=axis)
def _gelu(x):
    return torch.nn.functional.gelu(x, approximate="tanh")
def _silu(x):
    return torch.nn.functional.silu(x)
def _sigmoid(x):
    return torch.sigmoid(x)
def _layernorm(x, axis=-1, eps=1e-5):
    m = x.mean(dim=axis, keepdim=True)
    v = x.var(dim=axis, keepdim=True, unbiased=False)
    return (x - m) / torch.sqrt(v + eps)
def _scatter_add(tgt, idx, src, axis=0):
    return tgt.clone().index_add_(axis, idx, src)
def _segment_sum(src, seg, n):
    out = torch.zeros((n,) + src.shape[1:], dtype=src.dtype)
    return out.index_add_(0, seg, src)
def _pad(x, pw):
    flat = tuple(v for pair in reversed(pw) for v in pair)
    return torch.nn.functional.pad(x, flat)

kernel_name = 'standalone__kv_cache_quant_int4_int2_kv_with_per_channel_or_per_token_scales__decode'

def setup_inputs():

    _w = (lambda a: (lambda t: t.to(torch.bfloat16) if t.is_floating_point() else t)(torch.as_tensor(a)))
    B = 2
    Sq = 1
    Skv = 32768
    Hq = 32
    Hkv = 8
    Dh = 128
    bits = 3
    G = 32
    if G <= 0 or G >= Skv:
        G = max(1, Skv // 2)
    Skv = (Skv // G) * G
    ngk = Skv // G
    qmax = (1 << bits) - 1
    return {
        "q": _w((lambda *s: torch.randn(*s, dtype=torch.bfloat16) * 1.6)(B, Hq, Sq, Dh)),
        "qk": _w(torch.randint(0, qmax + 1, (B, Hkv, Skv, Dh)).to(torch.int32)),
        "qv": _w(torch.randint(0, qmax + 1, (B, Hkv, Skv, Dh)).to(torch.int32)),
        "k_scales": _w(torch.abs((lambda *s: torch.randn(*s, dtype=torch.bfloat16) * 1.6)(B, Hkv, ngk, Dh)) * 0.05 + 0.02),
        "k_zeros": _w((lambda *s: torch.randn(*s, dtype=torch.bfloat16) * 1.6)(B, Hkv, ngk, Dh) + float(qmax) / 2.0),
        "v_scales": _w(torch.abs((lambda *s: torch.randn(*s, dtype=torch.bfloat16) * 0.05)(B, Hkv, Skv, 1)) * 0.05 + 0.02),
        "v_zeros": _w((lambda *s: torch.randn(*s, dtype=torch.bfloat16) * 0.05)(B, Hkv, Skv, 1) + float(qmax) / 2.0),
    }

def reference(q, qk, qv, k_scales, k_zeros, v_scales, v_zeros):
    B, Hq, Sq, Dh = q.shape
    Hkv, Skv = qk.shape[1], qk.shape[2]
    ngk = k_scales.shape[2]
    G = Skv // ngk
    ks = (lambda x, n, axis: torch.repeat_interleave(x, n, dim=axis))(k_scales, G, axis=2)
    kz = (lambda x, n, axis: torch.repeat_interleave(x, n, dim=axis))(k_zeros, G, axis=2)
    k = ((lambda x, dt: x.to(dt))(qk, q.dtype) - kz) * ks
    v = ((lambda x, dt: x.to(dt))(qv, q.dtype) - v_zeros) * v_scales
    rep = Hq // Hkv
    if rep > 1:
        k = (lambda x, n, axis: torch.repeat_interleave(x, n, dim=axis))(k, rep, axis=1)
        v = (lambda x, n, axis: torch.repeat_interleave(x, n, dim=axis))(v, rep, axis=1)
    scale = float(Dh) ** -0.5
    logits = torch.einsum("bhqd,bhkd->bhqk", q, k) * scale
    p = _softmax(logits, axis=-1)
    o = torch.einsum("bhqk,bhkd->bhqd", p, v)
    return o
```

```asm
; @launch grid=(256,1,1) block=(320,1,1) lds=150016
.amdgcn_target "amdgcn-amd-amdhsa--gfx950"
.text
.globl standalone__kv_cache_quant_int4_int2_kv_with_per_channel_or_per_token_scales__decode_kernel
.p2align 8
.type standalone__kv_cache_quant_int4_int2_kv_with_per_channel_or_per_token_scales__decode_kernel,@function
standalone__kv_cache_quant_int4_int2_kv_with_per_channel_or_per_token_scales__decode_kernel:
  s_cmp_ge_u32 s2, 256
  s_cbranch_scc1 L_end
  s_load_dwordx16 s[4:19], s[0:1], 0
  s_load_dwordx4 s[20:23], s[0:1], 64
  v_lshrrev_b32 v1, 6, v0
  v_and_b32 v0, 63, v0
  v_readfirstlane_b32 s3, v1
  s_lshr_b32 s50, s2, 4
  s_and_b32 s51, s2, 7
  s_bfe_u32 s52, s2, 0x10003
  s_lshl1_add_u32 s51, s51, s52
  s_cmp_lg_u32 s3, 0
  s_cbranch_scc1 L_cons
  s_setprio 3
  v_lshrrev_b32 v5, 5, v0
  v_xor_b32 v1, v0, v5
  v_lshlrev_b32 v1, 4, v1
  v_xor_b32 v2, 64, v1
  v_xor_b32 v3, 0x80, v1
  v_xor_b32 v4, 0xc0, v1
  s_lshr_b32 s53, s51, 1
  s_lshl_b32 s53, s53, 21
  s_lshl_b32 s52, s52, 15
  s_add_u32 s53, s53, s52
  s_add_u32 s53, s53, 131072
  s_lshl_b32 s28, s50, 24
  s_mov_b32 s26, 0x1000000
  s_mov_b32 s27, 0x20000
  s_mov_b32 s30, s53
  s_mov_b32 s34, 0
  s_mov_b32 s31, 8
  s_add_u32 s33, s53, 1900544
  s_waitcnt lgkmcnt(0)
  s_add_u32 s24, s6, s28
  s_addc_u32 s25, s7, 0
L_l0:
  s_mov_b32 m0, s34
  s_add_u32 s34, s34, 0x1000
  buffer_load_dwordx4 v1, s[24:27], s30 offen offset:0 nt lds
  buffer_load_dwordx4 v2, s[24:27], s30 offen offset:1024 nt lds
  buffer_load_dwordx4 v3, s[24:27], s30 offen offset:2048 nt lds
  buffer_load_dwordx4 v4, s[24:27], s30 offen offset:3072 nt lds
  s_add_u32 s30, s30, 0x1000
  s_cmp_lt_u32 s34, 16384
  s_cbranch_scc1 L_l0
  s_sub_u32 s31, s31, 4
  s_mov_b32 s40, 58
  s_mov_b32 s41, 0
  s_mov_b32 s38, -1
  s_mov_b32 s39, 0xff
  v_mov_b32 v10, 1
  s_mov_b32 s44, s22
  s_mov_b32 s45, s23
  s_mov_b32 s46, 2097152
  s_mov_b32 s47, 0x20000
  s_mul_i32 s49, s50, 40960
  s_add_u32 s49, s49, 720896
  v_mov_b32 v16, s14
  v_mov_b32 v17, s15
  v_mov_b32 v14, 64
  s_sub_u32 s42, s16, 64
  s_subb_u32 s43, s17, 0
  s_mov_b32 exec_lo, 0xffffff0
  s_mov_b32 exec_hi, 0
  v_mov_b32 v16, s42
  v_mov_b32 v17, s43
  s_sub_u32 s42, s10, 128
  s_subb_u32 s43, s11, 0
  s_mov_b32 exec_lo, 0xffffff00
  s_mov_b32 exec_hi, 0xff
  v_mov_b32 v16, s42
  v_mov_b32 v17, s43
  v_mov_b32 v14, 256
  s_sub_u32 s42, s12, 384
  s_subb_u32 s43, s13, 0
  s_mov_b32 exec_lo, 0xff000000
  s_mov_b32 exec_hi, 0xff
  v_mov_b32 v16, s42
  v_mov_b32 v17, s43
  s_mov_b64 exec, -1
  v_lshlrev_b32 v8, 4, v0
  v_add_co_u32 v16, vcc, v16, v8
  s_nop 1
  v_addc_co_u32 v17, vcc, 0, v17, vcc
L_lk:
  s_mov_b32 m0, s34
  s_waitcnt vmcnt(19)
  buffer_load_dwordx4 v1, s[24:27], s30 offen offset:0 nt lds
  s_waitcnt vmcnt(19)
  buffer_load_dwordx4 v2, s[24:27], s30 offen offset:1024 nt lds
  s_waitcnt vmcnt(19)
  buffer_load_dwordx4 v3, s[24:27], s30 offen offset:2048 nt lds
  s_waitcnt vmcnt(19)
  s_sub_u32 s31, s31, 1
  s_cbranch_scc0 L_lk_nb
  s_barrier
  s_mov_b32 s31, 3
L_lk_nb:
  buffer_load_dwordx4 v4, s[24:27], s30 offen offset:3072 nt lds
  s_add_u32 s30, s30, 0x1000
  s_add_u32 s34, s34, 0x1000
  s_and_b32 s34, s34, 0xffff
  s_and_b32 s35, s30, 0x7000
  s_cselect_b32 s35, 0, 0x8000
  s_add_u32 s30, s30, s35
  s_cmp_lt_u32 s30, s33
  s_cbranch_scc1 L_lk
  v_mov_b32 v8, 149760
  ds_read_b32 v9, v8 offset:48
  s_mul_i32 s37, s50, 4096
  s_add_u32 s37, s37, 591872
  v_mov_b32 v11, s37
  v_mov_b32 v12, -1
  v_mov_b32 v13, -1
  s_add_u32 s36, s40, 2
  s_waitcnt lgkmcnt(0)
  v_readfirstlane_b32 s48, v9
L_pk:
  s_cmp_lt_u32 s40, s36
  s_cbranch_scc1 L_pk_own0
  v_readfirstlane_b32 s41, v12
  s_cmp_ge_u32 s41, 64
  s_cbranch_scc1 L_pk_end
  s_bfe_u32 s42, s41, 0x30001
  s_lshl_b32 s30, s42, 21
  s_and_b32 s42, s41, 1
  s_lshl_b32 s42, s42, 15
  s_add_u32 s30, s30, s42
  s_lshr_b32 s42, s41, 5
  s_lshl_b32 s42, s42, 16
  s_add_u32 s30, s30, s42
  s_bfe_u32 s42, s41, 0x10004
  s_lshl_b32 s42, s42, 14
  s_add_u32 s30, s30, s42
  s_lshr_b32 s42, s30, 14
  s_lshl_b32 s43, s50, 10
  s_add_u32 s42, s42, s43
  v_mad_u64_u32 v[18:19], s[56:57], v14, s42, v[16:17]
  s_and_b32 s43, s40, 7
  s_mul_i32 s43, s43, 1280
  s_add_u32 m0, s43, 139776
  s_mov_b64 exec, s[38:39]
  s_waitcnt vmcnt(21)
  global_load_lds_dwordx4 v[18:19], off nt
L_pk_own0:
  s_cmp_eq_u32 s48, 0
  s_cbranch_scc1 L_pk_noc0
  s_mov_b64 exec, 1
  s_and_b32 s43, s40, 7
  s_lshl2_add_u32 s43, s43, 149824
  v_mov_b32 v8, s43
  v_mov_b32 v9, s41
  ds_write_b32 v8, v9
  s_waitcnt vmcnt(21)
  global_atomic_add v12, v11, v10, s[22:23] sc0 sc1
L_pk_noc0:
  s_mov_b64 exec, -1
  s_mov_b32 m0, s34
  s_waitcnt vmcnt(21)
  buffer_load_dwordx4 v1, s[24:27], s30 offen offset:0 nt lds
  s_waitcnt vmcnt(21)
  buffer_load_dwordx4 v2, s[24:27], s30 offen offset:1024 nt lds
  s_waitcnt vmcnt(21)
  buffer_load_dwordx4 v3, s[24:27], s30 offen offset:2048 nt lds
  s_waitcnt vmcnt(21)
  buffer_load_dwordx4 v4, s[24:27], s30 offen offset:3072 nt lds
  s_add_u32 s30, s30, 0x1000
  s_add_u32 s34, s34, 0x1000
  s_mov_b32 m0, s34
  s_waitcnt vmcnt(21)
  buffer_load_dwordx4 v1, s[24:27], s30 offen offset:0 nt lds
  s_waitcnt vmcnt(21) lgkmcnt(0)
  s_barrier
  buffer_load_dwordx4 v2, s[24:27], s30 offen offset:1024 nt lds
  s_waitcnt vmcnt(21)
  buffer_load_dwordx4 v3, s[24:27], s30 offen offset:2048 nt lds
  s_waitcnt vmcnt(21)
  buffer_load_dwordx4 v4, s[24:27], s30 offen offset:3072 nt lds
  s_add_u32 s30, s30, 0x1000
  s_add_u32 s34, s34, 0x1000
  s_mov_b32 m0, s34
  s_waitcnt vmcnt(21)
  buffer_load_dwordx4 v1, s[24:27], s30 offen offset:0 nt lds
  s_waitcnt vmcnt(21)
  buffer_load_dwordx4 v2, s[24:27], s30 offen offset:1024 nt lds
  s_waitcnt vmcnt(21)
  buffer_load_dwordx4 v3, s[24:27], s30 offen offset:2048 nt lds
  s_waitcnt vmcnt(21)
  buffer_load_dwordx4 v4, s[24:27], s30 offen offset:3072 nt lds
  s_add_u32 s30, s30, 0x1000
  s_add_u32 s34, s34, 0x1000
  s_mov_b32 m0, s34
  s_waitcnt vmcnt(21)
  buffer_load_dwordx4 v1, s[24:27], s30 offen offset:0 nt lds
  s_waitcnt vmcnt(21)
  buffer_load_dwordx4 v2, s[24:27], s30 offen offset:1024 nt lds
  s_waitcnt vmcnt(21)
  buffer_load_dwordx4 v3, s[24:27], s30 offen offset:2048 nt lds
  s_waitcnt vmcnt(21)
  buffer_load_dwordx4 v4, s[24:27], s30 offen offset:3072 nt lds
  s_add_u32 s30, s30, 0x1000
  s_add_u32 s34, s34, 0x1000
  s_and_b32 s34, s34, 0xffff
  s_add_u32 s40, s40, 1
  s_cmp_lt_u32 s40, s36
  s_cbranch_scc1 L_pk_own1
  v_readfirstlane_b32 s41, v13
  s_cmp_ge_u32 s41, 64
  s_cbranch_scc1 L_pk_end
  s_bfe_u32 s42, s41, 0x30001
  s_lshl_b32 s30, s42, 21
  s_and_b32 s42, s41, 1
  s_lshl_b32 s42, s42, 15
  s_add_u32 s30, s30, s42
  s_lshr_b32 s42, s41, 5
  s_lshl_b32 s42, s42, 16
  s_add_u32 s30, s30, s42
  s_bfe_u32 s42, s41, 0x10004
  s_lshl_b32 s42, s42, 14
  s_add_u32 s30, s30, s42
  s_lshr_b32 s42, s30, 14
  s_lshl_b32 s43, s50, 10
  s_add_u32 s42, s42, s43
  v_mad_u64_u32 v[18:19], s[56:57], v14, s42, v[16:17]
  s_and_b32 s43, s40, 7
  s_mul_i32 s43, s43, 1280
  s_add_u32 m0, s43, 139776
  s_mov_b64 exec, s[38:39]
  s_waitcnt vmcnt(21)
  global_load_lds_dwordx4 v[18:19], off nt
L_pk_own1:
  s_cmp_eq_u32 s48, 0
  s_cbranch_scc1 L_pk_noc1
  s_mov_b64 exec, 1
  s_and_b32 s43, s40, 7
  s_lshl2_add_u32 s43, s43, 149824
  v_mov_b32 v8, s43
  v_mov_b32 v9, s41
  ds_write_b32 v8, v9
  s_waitcnt vmcnt(21)
  global_atomic_add v13, v11, v10, s[22:23] sc0 sc1
L_pk_noc1:
  s_mov_b64 exec, -1
  s_mov_b32 m0, s34
  s_waitcnt vmcnt(21)
  buffer_load_dwordx4 v1, s[24:27], s30 offen offset:0 nt lds
  s_waitcnt vmcnt(21)
  buffer_load_dwordx4 v2, s[24:27], s30 offen offset:1024 nt lds
  s_waitcnt vmcnt(21)
  buffer_load_dwordx4 v3, s[24:27], s30 offen offset:2048 nt lds
  s_waitcnt vmcnt(21)
  buffer_load_dwordx4 v4, s[24:27], s30 offen offset:3072 nt lds
  s_add_u32 s30, s30, 0x1000
  s_add_u32 s34, s34, 0x1000
  s_mov_b32 m0, s34
  s_waitcnt vmcnt(21)
  buffer_load_dwordx4 v1, s[24:27], s30 offen offset:0 nt lds
  s_waitcnt vmcnt(21) lgkmcnt(0)
  s_barrier
  buffer_load_dwordx4 v2, s[24:27], s30 offen offset:1024 nt lds
  s_waitcnt vmcnt(21)
  buffer_load_dwordx4 v3, s[24:27], s30 offen offset:2048 nt lds
  s_waitcnt vmcnt(21)
  buffer_load_dwordx4 v4, s[24:27], s30 offen offset:3072 nt lds
  s_add_u32 s30, s30, 0x1000
  s_add_u32 s34, s34, 0x1000
  s_mov_b32 m0, s34
  s_waitcnt vmcnt(21)
  buffer_load_dwordx4 v1, s[24:27], s30 offen offset:0 nt lds
  s_waitcnt vmcnt(21)
  buffer_load_dwordx4 v2, s[24:27], s30 offen offset:1024 nt lds
  s_waitcnt vmcnt(21)
  buffer_load_dwordx4 v3, s[24:27], s30 offen offset:2048 nt lds
  s_waitcnt vmcnt(21)
  buffer_load_dwordx4 v4, s[24:27], s30 offen offset:3072 nt lds
  s_add_u32 s30, s30, 0x1000
  s_add_u32 s34, s34, 0x1000
  s_mov_b32 m0, s34
  s_waitcnt vmcnt(21)
  buffer_load_dwordx4 v1, s[24:27], s30 offen offset:0 nt lds
  s_waitcnt vmcnt(21)
  buffer_load_dwordx4 v2, s[24:27], s30 offen offset:1024 nt lds
  s_waitcnt vmcnt(21)
  buffer_load_dwordx4 v3, s[24:27], s30 offen offset:2048 nt lds
  s_waitcnt vmcnt(21)
  buffer_load_dwordx4 v4, s[24:27], s30 offen offset:3072 nt lds
  s_add_u32 s30, s30, 0x1000
  s_add_u32 s34, s34, 0x1000
  s_and_b32 s34, s34, 0xffff
  s_add_u32 s40, s40, 1
  s_branch L_pk
L_pk_end:
  s_sub_u32 s42, s40, 1
  v_mov_b32 v8, 149760
  v_mov_b32 v9, s42
  ds_write_b32 v8, v9 offset:32
  s_add_u32 s24, s8, s28
  s_addc_u32 s25, s9, 0
  s_add_u32 s30, s53, 0
  v_lshlrev_b32 v1, 4, v0
  v_lshlrev_b32 v2, 4, v0
  v_lshlrev_b32 v3, 4, v0
  v_lshlrev_b32 v4, 4, v0
  s_mov_b32 s31, 0
  s_add_u32 s33, s53, 1900544
  s_add_u32 s40, s40, 58
  s_waitcnt lgkmcnt(0)
L_lv:
  s_mov_b32 m0, s34
  s_waitcnt vmcnt(19)
  buffer_load_dwordx4 v1, s[24:27], s30 offen offset:0 nt lds
  s_waitcnt vmcnt(19)
  buffer_load_dwordx4 v2, s[24:27], s30 offen offset:1024 nt lds
  s_waitcnt vmcnt(19)
  buffer_load_dwordx4 v3, s[24:27], s30 offen offset:2048 nt lds
  s_waitcnt vmcnt(19)
  s_sub_u32 s31, s31, 1
  s_cbranch_scc0 L_lv_nb
  s_barrier
  s_mov_b32 s31, 3
L_lv_nb:
  buffer_load_dwordx4 v4, s[24:27], s30 offen offset:3072 nt lds
  s_add_u32 s30, s30, 0x1000
  s_add_u32 s34, s34, 0x1000
  s_and_b32 s34, s34, 0xffff
  s_and_b32 s35, s30, 0x7000
  s_cselect_b32 s35, 0, 0x8000
  s_add_u32 s30, s30, s35
  s_cmp_lt_u32 s30, s33
  s_cbranch_scc1 L_lv
  v_mov_b32 v8, 149760
  ds_read_b32 v9, v8 offset:16
  s_mul_i32 s37, s50, 4096
  s_add_u32 s37, s37, 589824
  v_mov_b32 v11, s37
  v_mov_b32 v12, -1
  v_mov_b32 v13, -1
  s_add_u32 s36, s40, 2
  s_waitcnt lgkmcnt(0)
  v_readfirstlane_b32 s48, v9
L_pv:
  s_cmp_lt_u32 s40, s36
  s_cbranch_scc1 L_pv_own0
  v_readfirstlane_b32 s41, v12
  s_cmp_ge_u32 s41, 64
  s_cbranch_scc1 L_pv_end
  s_bfe_u32 s42, s41, 0x30001
  s_lshl_b32 s30, s42, 21
  s_and_b32 s42, s41, 1
  s_lshl_b32 s42, s42, 15
  s_add_u32 s30, s30, s42
  s_lshr_b32 s42, s41, 5
  s_lshl_b32 s42, s42, 16
  s_add_u32 s30, s30, s42
  s_bfe_u32 s42, s41, 0x10004
  s_lshl_b32 s42, s42, 14
  s_add_u32 s30, s30, s42
  s_mul_i32 s42, s41, 640
  s_add_u32 s42, s42, s49
  s_lshr_b32 s43, s34, 4
  s_add_u32 m0, s43, 139264
  s_mov_b64 exec, s[38:39]
  s_waitcnt vmcnt(21)
  buffer_load_dwordx4 v1, s[44:47], s42 offen sc1 lds
L_pv_own0:
  s_cmp_eq_u32 s48, 0
  s_cbranch_scc1 L_pv_noc0
  s_mov_b64 exec, 1
  s_waitcnt vmcnt(21)
  global_atomic_add v12, v11, v10, s[22:23] sc0 sc1
L_pv_noc0:
  s_mov_b64 exec, -1
  s_mov_b32 m0, s34
  s_waitcnt vmcnt(21)
  buffer_load_dwordx4 v1, s[24:27], s30 offen offset:0 nt lds
  s_waitcnt vmcnt(21)
  buffer_load_dwordx4 v2, s[24:27], s30 offen offset:1024 nt lds
  s_waitcnt vmcnt(21)
  buffer_load_dwordx4 v3, s[24:27], s30 offen offset:2048 nt lds
  s_waitcnt vmcnt(21)
  buffer_load_dwordx4 v4, s[24:27], s30 offen offset:3072 nt lds
  s_add_u32 s30, s30, 0x1000
  s_add_u32 s34, s34, 0x1000
  s_mov_b32 m0, s34
  s_waitcnt vmcnt(21)
  buffer_load_dwordx4 v1, s[24:27], s30 offen offset:0 nt lds
  s_waitcnt vmcnt(21) lgkmcnt(0)
  s_barrier
  buffer_load_dwordx4 v2, s[24:27], s30 offen offset:1024 nt lds
  s_waitcnt vmcnt(21)
  buffer_load_dwordx4 v3, s[24:27], s30 offen offset:2048 nt lds
  s_waitcnt vmcnt(21)
  buffer_load_dwordx4 v4, s[24:27], s30 offen offset:3072 nt lds
  s_add_u32 s30, s30, 0x1000
  s_add_u32 s34, s34, 0x1000
  s_mov_b32 m0, s34
  s_waitcnt vmcnt(21)
  buffer_load_dwordx4 v1, s[24:27], s30 offen offset:0 nt lds
  s_waitcnt vmcnt(21)
  buffer_load_dwordx4 v2, s[24:27], s30 offen offset:1024 nt lds
  s_waitcnt vmcnt(21)
  buffer_load_dwordx4 v3, s[24:27], s30 offen offset:2048 nt lds
  s_waitcnt vmcnt(21)
  buffer_load_dwordx4 v4, s[24:27], s30 offen offset:3072 nt lds
  s_add_u32 s30, s30, 0x1000
  s_add_u32 s34, s34, 0x1000
  s_mov_b32 m0, s34
  s_waitcnt vmcnt(21)
  buffer_load_dwordx4 v1, s[24:27], s30 offen offset:0 nt lds
  s_waitcnt vmcnt(21)
  buffer_load_dwordx4 v2, s[24:27], s30 offen offset:1024 nt lds
  s_waitcnt vmcnt(21)
  buffer_load_dwordx4 v3, s[24:27], s30 offen offset:2048 nt lds
  s_waitcnt vmcnt(21)
  buffer_load_dwordx4 v4, s[24:27], s30 offen offset:3072 nt lds
  s_add_u32 s30, s30, 0x1000
  s_add_u32 s34, s34, 0x1000
  s_and_b32 s34, s34, 0xffff
  s_add_u32 s40, s40, 1
  s_cmp_lt_u32 s40, s36
  s_cbranch_scc1 L_pv_own1
  v_readfirstlane_b32 s41, v13
  s_cmp_ge_u32 s41, 64
  s_cbranch_scc1 L_pv_end
  s_bfe_u32 s42, s41, 0x30001
  s_lshl_b32 s30, s42, 21
  s_and_b32 s42, s41, 1
  s_lshl_b32 s42, s42, 15
  s_add_u32 s30, s30, s42
  s_lshr_b32 s42, s41, 5
  s_lshl_b32 s42, s42, 16
  s_add_u32 s30, s30, s42
  s_bfe_u32 s42, s41, 0x10004
  s_lshl_b32 s42, s42, 14
  s_add_u32 s30, s30, s42
  s_mul_i32 s42, s41, 640
  s_add_u32 s42, s42, s49
  s_lshr_b32 s43, s34, 4
  s_add_u32 m0, s43, 139264
  s_mov_b64 exec, s[38:39]
  s_waitcnt vmcnt(21)
  buffer_load_dwordx4 v1, s[44:47], s42 offen sc1 lds
L_pv_own1:
  s_cmp_eq_u32 s48, 0
  s_cbranch_scc1 L_pv_noc1
  s_mov_b64 exec, 1
  s_waitcnt vmcnt(21)
  global_atomic_add v13, v11, v10, s[22:23] sc0 sc1
L_pv_noc1:
  s_mov_b64 exec, -1
  s_mov_b32 m0, s34
  s_waitcnt vmcnt(21)
  buffer_load_dwordx4 v1, s[24:27], s30 offen offset:0 nt lds
  s_waitcnt vmcnt(21)
  buffer_load_dwordx4 v2, s[24:27], s30 offen offset:1024 nt lds
  s_waitcnt vmcnt(21)
  buffer_load_dwordx4 v3, s[24:27], s30 offen offset:2048 nt lds
  s_waitcnt vmcnt(21)
  buffer_load_dwordx4 v4, s[24:27], s30 offen offset:3072 nt lds
  s_add_u32 s30, s30, 0x1000
  s_add_u32 s34, s34, 0x1000
  s_mov_b32 m0, s34
  s_waitcnt vmcnt(21)
  buffer_load_dwordx4 v1, s[24:27], s30 offen offset:0 nt lds
  s_waitcnt vmcnt(21) lgkmcnt(0)
  s_barrier
  buffer_load_dwordx4 v2, s[24:27], s30 offen offset:1024 nt lds
  s_waitcnt vmcnt(21)
  buffer_load_dwordx4 v3, s[24:27], s30 offen offset:2048 nt lds
  s_waitcnt vmcnt(21)
  buffer_load_dwordx4 v4, s[24:27], s30 offen offset:3072 nt lds
  s_add_u32 s30, s30, 0x1000
  s_add_u32 s34, s34, 0x1000
  s_mov_b32 m0, s34
  s_waitcnt vmcnt(21)
  buffer_load_dwordx4 v1, s[24:27], s30 offen offset:0 nt lds
  s_waitcnt vmcnt(21)
  buffer_load_dwordx4 v2, s[24:27], s30 offen offset:1024 nt lds
  s_waitcnt vmcnt(21)
  buffer_load_dwordx4 v3, s[24:27], s30 offen offset:2048 nt lds
  s_waitcnt vmcnt(21)
  buffer_load_dwordx4 v4, s[24:27], s30 offen offset:3072 nt lds
  s_add_u32 s30, s30, 0x1000
  s_add_u32 s34, s34, 0x1000
  s_mov_b32 m0, s34
  s_waitcnt vmcnt(21)
  buffer_load_dwordx4 v1, s[24:27], s30 offen offset:0 nt lds
  s_waitcnt vmcnt(21)
  buffer_load_dwordx4 v2, s[24:27], s30 offen offset:1024 nt lds
  s_waitcnt vmcnt(21)
  buffer_load_dwordx4 v3, s[24:27], s30 offen offset:2048 nt lds
  s_waitcnt vmcnt(21)
  buffer_load_dwordx4 v4, s[24:27], s30 offen offset:3072 nt lds
  s_add_u32 s30, s30, 0x1000
  s_add_u32 s34, s34, 0x1000
  s_and_b32 s34, s34, 0xffff
  s_add_u32 s40, s40, 1
  s_branch L_pv
L_pv_end:
  s_sub_u32 s42, s40, 1
  v_mov_b32 v8, 149760
  v_mov_b32 v9, s42
  ds_write_b32 v8, v9 offset:0
  s_waitcnt vmcnt(16) lgkmcnt(0)
  s_barrier
  s_waitcnt vmcnt(0)
  s_barrier
  s_endpgm
L_cons:
  s_sub_u32 s3, s3, 1
  v_and_b32 v1, 15, v0
  v_lshrrev_b32 v2, 4, v0
  v_lshlrev_b32 v3, 4, v0
  v_and_b32 v92, 3, v1
  v_bfe_u32 v93, v1, 2, 1
  v_lshlrev_b32 v94, 4, v2
  v_lshl_add_u32 v110, v93, 7, v94
  v_lshl_add_u32 v95, v92, 8, v110
  v_add_u32 v8, 99328, v110
  v_lshrrev_b32 v93, 5, v0
  v_and_b32 v12, 31, v0
  v_lshlrev_b32 v12, 4, v12
  v_lshl_add_u32 v12, v93, 10, v12
  v_lshrrev_b32 v93, 3, v0
  v_and_b32 v13, 7, v0
  v_lshlrev_b32 v13, 4, v13
  v_lshl_add_u32 v13, v93, 8, v13
  s_lshr_b32 s53, s51, 1
  s_lshl_b32 s53, s53, 7
  s_lshl1_add_u32 s53, s52, s53
  s_lshl_b32 s52, s50, 10
  s_add_u32 s53, s53, s52
  s_lshl_b32 s54, s53, 6
  s_lshl_b32 s53, s53, 8
  s_lshl_b32 s55, s3, 10
  s_lshl_b32 s57, s3, 11
  s_mov_b32 s26, 0x4000
  s_mov_b32 s27, 0x20000
  s_mov_b32 s30, 32256
  s_mov_b32 s31, 0x20000
  s_mov_b32 s34, 32256
  s_mov_b32 s35, 0x20000
  s_mov_b32 s38, 8064
  s_mov_b32 s39, 0x20000
  s_mov_b32 s42, 8064
  s_mov_b32 s43, 0x20000
  s_cmp_lt_u32 s3, 1
  s_cselect_b32 s56, 0x7ffffff0, s57
  s_waitcnt lgkmcnt(0)
  s_mov_b32 s24, s4
  s_mov_b32 s25, s5
  buffer_load_dwordx4 v[32:35], v95, s[24:27], s52 offen
  buffer_load_dwordx4 v[36:39], v95, s[24:27], s52 offen offset:64
  s_add_u32 s28, s10, s53
  s_addc_u32 s29, s11, 0
  s_add_u32 s32, s12, s53
  s_addc_u32 s33, s13, 0
  s_add_u32 s36, s14, s54
  s_addc_u32 s37, s15, 0
  s_add_u32 s40, s16, s54
  s_addc_u32 s41, s17, 0
  s_add_u32 m0, s55, 98304
  s_nop 0
  buffer_load_dwordx4 v12, s[28:31], s56 offen nt lds
  s_add_u32 m0, s55, 114688
  s_nop 0
  buffer_load_dwordx4 v12, s[32:35], s56 offen nt lds
  s_add_u32 s56, s57, 8192
  s_add_u32 m0, s55, 102400
  s_nop 0
  buffer_load_dwordx4 v12, s[28:31], s56 offen nt lds
  s_add_u32 m0, s55, 118784
  s_nop 0
  buffer_load_dwordx4 v12, s[32:35], s56 offen nt lds
  s_add_u32 s56, s57, 16384
  s_add_u32 m0, s55, 106496
  s_nop 0
  buffer_load_dwordx4 v12, s[28:31], s56 offen nt lds
  s_add_u32 m0, s55, 122880
  s_nop 0
  buffer_load_dwordx4 v12, s[32:35], s56 offen nt lds
  s_add_u32 s56, s57, 24576
  s_add_u32 m0, s55, 110592
  s_nop 0
  buffer_load_dwordx4 v12, s[28:31], s56 offen nt lds
  s_add_u32 m0, s55, 126976
  s_nop 0
  buffer_load_dwordx4 v12, s[32:35], s56 offen nt lds
  s_add_u32 m0, s55, 131072
  s_nop 0
  buffer_load_dwordx4 v13, s[36:39], s57 offen nt lds
  s_add_u32 m0, s55, 135168
  s_nop 0
  buffer_load_dwordx4 v13, s[40:43], s57 offen nt lds
  s_mov_b32 s44, s22
  s_mov_b32 s45, s23
  s_mov_b32 s46, 2097152
  s_mov_b32 s47, 0x20000
  s_mul_i32 s53, s50, 4096
  s_add_u32 s53, s53, 589824
  s_add_u32 s54, s51, s3
  s_cmp_eq_u32 s54, 0
  s_cselect_b32 s53, s53, 0x7ffffff0
  v_mov_b32 v93, 0
  s_mov_b64 exec, 1
  buffer_store_dword v93, v3, s[44:47], s53 offen sc1
  buffer_store_dword v93, v3, s[44:47], s53 offen offset:1024 sc1
  buffer_store_dword v93, v3, s[44:47], s53 offen offset:2048 sc1
  s_mov_b64 exec, -1
  s_lshl2_add_u32 s56, s50, s3
  s_lshl_b32 s56, s56, 13
  s_lshl_b32 s57, s51, 9
  s_add_u32 s57, s57, s56
  s_lshl_b32 s63, s50, 9
  s_add_u32 s63, s63, 524288
  s_lshl_b32 s68, s51, 5
  s_add_u32 s68, s68, s63
  s_cmp_eq_u32 s3, 0
  s_cselect_b32 s68, s68, 0x7ffffff0
  v_lshlrev_b32 v104, 3, v0
  v_lshlrev_b32 v105, 3, v2
  v_and_b32 v93, 7, v1
  v_lshrrev_b32 v94, 3, v1
  v_lshlrev_b32 v111, 4, v2
  v_lshl_add_u32 v111, v94, 7, v111
  v_add_u32 v9, 115712, v111
  v_lshlrev_b32 v94, 4, v94
  v_lshl_add_u32 v94, v2, 1, v94
  v_and_b32 v95, 6, v93
  v_lshlrev_b32 v95, 1, v95
  v_and_or_b32 v95, v93, 1, v95
  v_xor_b32 v94, v94, v95
  v_lshlrev_b32 v94, 4, v94
  v_lshl_add_u32 v94, v93, 9, v94
  s_lshl_b32 s58, s3, 12
  v_add_u32 v4, s58, v94
  v_xor_b32 v5, 16, v4
  v_xor_b32 v6, 0x80, v4
  v_xor_b32 v7, 0x90, v4
  v_and_b32 v93, 1, v2
  v_lshrrev_b32 v94, 1, v2
  v_lshl_add_u32 v93, v93, 2, v94
  v_lshlrev_b32 v93, 2, v93
  v_lshl_add_u32 v93, v92, 7, v93
  s_lshl_b32 s58, s3, 5
  v_add_u32 v112, s58, v93
  v_add_u32 v10, 67584, v112
  v_lshlrev_b32 v93, 3, v1
  v_lshl_add_u32 v93, v2, 12, v93
  s_lshl_b32 s58, s3, 7
  v_add_u32 v12, s58, v93
  v_lshrrev_b32 v93, 2, v1
  v_lshlrev_b32 v94, 5, v2
  v_lshl_add_u32 v94, v93, 7, v94
  v_add_u32 v13, 67584, v94
  v_lshlrev_b32 v14, 4, v2
  v_add_u32 v14, 131328, v14
  v_mov_b32 v11, 0xff800000
  v_mov_b32 v15, 0
  v_mov_b32 v99, 149760
  v_mov_b32 v92, -1
  ds_write_b32 v99, v92 offset:0
  ds_write_b32 v99, v92 offset:32
  s_mov_b32 s48, 0x000f000f
  s_mov_b32 s49, 0x000f000f
  s_mov_b32 s58, 0xffff0000
  s_mov_b32 s38, -1
  s_mov_b32 s39, 0xff
  s_waitcnt vmcnt(13)
  v_lshlrev_b32 v16, 16, v32
  v_and_b32 v17, s58, v32
  v_lshlrev_b32 v18, 16, v33
  v_and_b32 v19, s58, v33
  v_lshlrev_b32 v20, 16, v34
  v_and_b32 v21, s58, v34
  v_lshlrev_b32 v22, 16, v35
  v_and_b32 v23, s58, v35
  v_lshlrev_b32 v24, 16, v36
  v_and_b32 v25, s58, v36
  v_lshlrev_b32 v26, 16, v37
  v_and_b32 v27, s58, v37
  v_lshlrev_b32 v28, 16, v38
  v_and_b32 v29, s58, v38
  v_lshlrev_b32 v30, 16, v39
  v_and_b32 v31, s58, v39
  v_mul_f32 v16, 0x3e0293ee, v16
  v_mul_f32 v17, 0x3e0293ee, v17
  v_mul_f32 v18, 0x3e0293ee, v18
  v_mul_f32 v19, 0x3e0293ee, v19
  v_mul_f32 v20, 0x3e0293ee, v20
  v_mul_f32 v21, 0x3e0293ee, v21
  v_mul_f32 v22, 0x3e0293ee, v22
  v_mul_f32 v23, 0x3e0293ee, v23
  v_mul_f32 v24, 0x3e0293ee, v24
  v_mul_f32 v25, 0x3e0293ee, v25
  v_mul_f32 v26, 0x3e0293ee, v26
  v_mul_f32 v27, 0x3e0293ee, v27
  v_mul_f32 v28, 0x3e0293ee, v28
  v_mul_f32 v29, 0x3e0293ee, v29
  v_mul_f32 v30, 0x3e0293ee, v30
  v_mul_f32 v31, 0x3e0293ee, v31
  s_lshr_b32 s71, s51, 1
  s_add_u32 s71, s71, 4
  s_mov_b32 s59, 0
  s_cmp_eq_u32 s51, 0
  s_cselect_b32 s55, 1, s71
  s_cmp_eq_u32 s3, 0
  s_cselect_b32 s55, s55, 99
  s_waitcnt vmcnt(11)
L_k:
  s_barrier
  ds_read_b128 v[48:51], v8 offset:0
  ds_read_b128 v[52:55], v8 offset:64
  ds_read_b128 v[32:35], v4 offset:0
  ds_read_b128 v[36:39], v5 offset:0
  ds_read_b128 v[40:43], v6 offset:0
  ds_read_b128 v[44:47], v7 offset:0
  ds_read_b128 v[56:59], v9 offset:0
  ds_read_b128 v[60:63], v9 offset:64
  s_waitcnt lgkmcnt(7)
  v_lshlrev_b32 v92, 16, v48
  v_and_b32 v93, s58, v48
  v_mul_f32 v92, v92, v16
  v_mul_f32 v93, v93, v17
  v_cvt_pk_bf16_f32 v72, v92, v93
  v_lshlrev_b32 v92, 16, v49
  v_and_b32 v93, s58, v49
  v_mul_f32 v92, v92, v18
  v_mul_f32 v93, v93, v19
  v_cvt_pk_bf16_f32 v73, v92, v93
  v_lshlrev_b32 v92, 16, v50
  v_and_b32 v93, s58, v50
  v_mul_f32 v92, v92, v20
  v_mul_f32 v93, v93, v21
  v_cvt_pk_bf16_f32 v74, v92, v93
  v_lshlrev_b32 v92, 16, v51
  v_and_b32 v93, s58, v51
  v_mul_f32 v92, v92, v22
  v_mul_f32 v93, v93, v23
  v_cvt_pk_bf16_f32 v75, v92, v93
  s_waitcnt lgkmcnt(6)
  v_lshlrev_b32 v92, 16, v52
  v_and_b32 v93, s58, v52
  v_mul_f32 v92, v92, v24
  v_mul_f32 v93, v93, v25
  v_cvt_pk_bf16_f32 v76, v92, v93
  v_lshlrev_b32 v92, 16, v53
  v_and_b32 v93, s58, v53
  v_mul_f32 v92, v92, v26
  v_mul_f32 v93, v93, v27
  v_cvt_pk_bf16_f32 v77, v92, v93
  v_lshlrev_b32 v92, 16, v54
  v_and_b32 v93, s58, v54
  v_mul_f32 v92, v92, v28
  v_mul_f32 v93, v93, v29
  v_cvt_pk_bf16_f32 v78, v92, v93
  v_lshlrev_b32 v92, 16, v55
  v_and_b32 v93, s58, v55
  v_mul_f32 v92, v92, v30
  v_mul_f32 v93, v93, v31
  v_cvt_pk_bf16_f32 v79, v92, v93
  s_waitcnt lgkmcnt(4)
  v_cvt_f32_i32 v32, v32
  v_cvt_f32_i32 v33, v33
  v_cvt_f32_i32 v34, v34
  v_cvt_f32_i32 v35, v35
  v_cvt_f32_i32 v36, v36
  v_cvt_f32_i32 v37, v37
  v_cvt_f32_i32 v38, v38
  v_cvt_f32_i32 v39, v39
  v_cvt_pk_bf16_f32 v64, v32, v33
  v_cvt_pk_bf16_f32 v65, v34, v35
  v_cvt_pk_bf16_f32 v66, v36, v37
  v_cvt_pk_bf16_f32 v67, v38, v39
  s_waitcnt lgkmcnt(2)
  v_cvt_f32_i32 v40, v40
  v_cvt_f32_i32 v41, v41
  v_cvt_f32_i32 v42, v42
  v_cvt_f32_i32 v43, v43
  v_cvt_f32_i32 v44, v44
  v_cvt_f32_i32 v45, v45
  v_cvt_f32_i32 v46, v46
  v_cvt_f32_i32 v47, v47
  v_cvt_pk_bf16_f32 v68, v40, v41
  v_cvt_pk_bf16_f32 v69, v42, v43
  v_cvt_pk_bf16_f32 v70, v44, v45
  v_cvt_pk_bf16_f32 v71, v46, v47
  s_waitcnt lgkmcnt(0)
  v_xor_b32 v56, 0x80008000, v56
  v_xor_b32 v57, 0x80008000, v57
  v_xor_b32 v58, 0x80008000, v58
  v_xor_b32 v59, 0x80008000, v59
  v_mfma_f32_16x16x32_bf16 v[80:83], v[64:67], v[72:75], 0
  v_xor_b32 v60, 0x80008000, v60
  v_xor_b32 v61, 0x80008000, v61
  v_xor_b32 v62, 0x80008000, v62
  v_xor_b32 v63, 0x80008000, v63
  v_mfma_f32_16x16x32_bf16 v[80:83], v[68:71], v[76:79], v[80:83]
  v_mfma_f32_16x16x32_bf16 v[80:83], v[56:59], v[72:75], v[80:83]
  v_mfma_f32_16x16x32_bf16 v[80:83], v[60:63], v[76:79], v[80:83]
  s_nop 7
  v_permlane32_swap_b32 v80, v81
  v_permlane32_swap_b32 v82, v83
  s_nop 1
  v_add_f32_dpp v92, v81, v80 row_shl:4 row_mask:0xf bank_mask:0xf bound_ctrl:1
  v_add_f32_dpp v93, v83, v82 row_shl:4 row_mask:0xf bank_mask:0xf bound_ctrl:1
  s_mov_b64 exec, s[48:49]
  ds_write_b32 v10, v92 offset:0
  ds_write_b32 v10, v93 offset:8
  v_max3_f32 v11, v11, v92, v93
  s_mov_b64 exec, -1
  s_barrier
  ds_read_b128 v[48:51], v8 offset:256
  ds_read_b128 v[52:55], v8 offset:320
  ds_read_b128 v[32:35], v4 offset:16384
  ds_read_b128 v[36:39], v5 offset:16384
  ds_read_b128 v[40:43], v6 offset:16384
  ds_read_b128 v[44:47], v7 offset:16384
  ds_read_b128 v[56:59], v9 offset:256
  ds_read_b128 v[60:63], v9 offset:320
  s_waitcnt lgkmcnt(7)
  v_lshlrev_b32 v92, 16, v48
  v_and_b32 v93, s58, v48
  v_mul_f32 v92, v92, v16
  v_mul_f32 v93, v93, v17
  v_cvt_pk_bf16_f32 v72, v92, v93
  v_lshlrev_b32 v92, 16, v49
  v_and_b32 v93, s58, v49
  v_mul_f32 v92, v92, v18
  v_mul_f32 v93, v93, v19
  v_cvt_pk_bf16_f32 v73, v92, v93
  v_lshlrev_b32 v92, 16, v50
  v_and_b32 v93, s58, v50
  v_mul_f32 v92, v92, v20
  v_mul_f32 v93, v93, v21
  v_cvt_pk_bf16_f32 v74, v92, v93
  v_lshlrev_b32 v92, 16, v51
  v_and_b32 v93, s58, v51
  v_mul_f32 v92, v92, v22
  v_mul_f32 v93, v93, v23
  v_cvt_pk_bf16_f32 v75, v92, v93
  s_waitcnt lgkmcnt(6)
  v_lshlrev_b32 v92, 16, v52
  v_and_b32 v93, s58, v52
  v_mul_f32 v92, v92, v24
  v_mul_f32 v93, v93, v25
  v_cvt_pk_bf16_f32 v76, v92, v93
  v_lshlrev_b32 v92, 16, v53
  v_and_b32 v93, s58, v53
  v_mul_f32 v92, v92, v26
  v_mul_f32 v93, v93, v27
  v_cvt_pk_bf16_f32 v77, v92, v93
  v_lshlrev_b32 v92, 16, v54
  v_and_b32 v93, s58, v54
  v_mul_f32 v92, v92, v28
  v_mul_f32 v93, v93, v29
  v_cvt_pk_bf16_f32 v78, v92, v93
  v_lshlrev_b32 v92, 16, v55
  v_and_b32 v93, s58, v55
  v_mul_f32 v92, v92, v30
  v_mul_f32 v93, v93, v31
  v_cvt_pk_bf16_f32 v79, v92, v93
  s_waitcnt lgkmcnt(4)
  v_cvt_f32_i32 v32, v32
  v_cvt_f32_i32 v33, v33
  v_cvt_f32_i32 v34, v34
  v_cvt_f32_i32 v35, v35
  v_cvt_f32_i32 v36, v36
  v_cvt_f32_i32 v37, v37
  v_cvt_f32_i32 v38, v38
  v_cvt_f32_i32 v39, v39
  v_cvt_pk_bf16_f32 v64, v32, v33
  v_cvt_pk_bf16_f32 v65, v34, v35
  v_cvt_pk_bf16_f32 v66, v36, v37
  v_cvt_pk_bf16_f32 v67, v38, v39
  s_waitcnt lgkmcnt(2)
  v_cvt_f32_i32 v40, v40
  v_cvt_f32_i32 v41, v41
  v_cvt_f32_i32 v42, v42
  v_cvt_f32_i32 v43, v43
  v_cvt_f32_i32 v44, v44
  v_cvt_f32_i32 v45, v45
  v_cvt_f32_i32 v46, v46
  v_cvt_f32_i32 v47, v47
  v_cvt_pk_bf16_f32 v68, v40, v41
  v_cvt_pk_bf16_f32 v69, v42, v43
  v_cvt_pk_bf16_f32 v70, v44, v45
  v_cvt_pk_bf16_f32 v71, v46, v47
  s_waitcnt lgkmcnt(0)
  v_xor_b32 v56, 0x80008000, v56
  v_xor_b32 v57, 0x80008000, v57
  v_xor_b32 v58, 0x80008000, v58
  v_xor_b32 v59, 0x80008000, v59
  v_mfma_f32_16x16x32_bf16 v[80:83], v[64:67], v[72:75], 0
  v_xor_b32 v60, 0x80008000, v60
  v_xor_b32 v61, 0x80008000, v61
  v_xor_b32 v62, 0x80008000, v62
  v_xor_b32 v63, 0x80008000, v63
  v_mfma_f32_16x16x32_bf16 v[80:83], v[68:71], v[76:79], v[80:83]
  v_mfma_f32_16x16x32_bf16 v[80:83], v[56:59], v[72:75], v[80:83]
  v_mfma_f32_16x16x32_bf16 v[80:83], v[60:63], v[76:79], v[80:83]
  s_nop 7
  v_permlane32_swap_b32 v80, v81
  v_permlane32_swap_b32 v82, v83
  s_nop 1
  v_add_f32_dpp v92, v81, v80 row_shl:4 row_mask:0xf bank_mask:0xf bound_ctrl:1
  v_add_f32_dpp v93, v83, v82 row_shl:4 row_mask:0xf bank_mask:0xf bound_ctrl:1
  s_mov_b64 exec, s[48:49]
  ds_write_b32 v10, v92 offset:512
  ds_write_b32 v10, v93 offset:520
  v_max3_f32 v11, v11, v92, v93
  s_mov_b64 exec, -1
  s_barrier
  ds_read_b128 v[48:51], v8 offset:512
  ds_read_b128 v[52:55], v8 offset:576
  ds_read_b128 v[32:35], v4 offset:32768
  ds_read_b128 v[36:39], v5 offset:32768
  ds_read_b128 v[40:43], v6 offset:32768
  ds_read_b128 v[44:47], v7 offset:32768
  ds_read_b128 v[56:59], v9 offset:512
  ds_read_b128 v[60:63], v9 offset:576
  s_waitcnt lgkmcnt(7)
  v_lshlrev_b32 v92, 16, v48
  v_and_b32 v93, s58, v48
  v_mul_f32 v92, v92, v16
  v_mul_f32 v93, v93, v17
  v_cvt_pk_bf16_f32 v72, v92, v93
  v_lshlrev_b32 v92, 16, v49
  v_and_b32 v93, s58, v49
  v_mul_f32 v92, v92, v18
  v_mul_f32 v93, v93, v19
  v_cvt_pk_bf16_f32 v73, v92, v93
  v_lshlrev_b32 v92, 16, v50
  v_and_b32 v93, s58, v50
  v_mul_f32 v92, v92, v20
  v_mul_f32 v93, v93, v21
  v_cvt_pk_bf16_f32 v74, v92, v93
  v_lshlrev_b32 v92, 16, v51
  v_and_b32 v93, s58, v51
  v_mul_f32 v92, v92, v22
  v_mul_f32 v93, v93, v23
  v_cvt_pk_bf16_f32 v75, v92, v93
  s_waitcnt lgkmcnt(6)
  v_lshlrev_b32 v92, 16, v52
  v_and_b32 v93, s58, v52
  v_mul_f32 v92, v92, v24
  v_mul_f32 v93, v93, v25
  v_cvt_pk_bf16_f32 v76, v92, v93
  v_lshlrev_b32 v92, 16, v53
  v_and_b32 v93, s58, v53
  v_mul_f32 v92, v92, v26
  v_mul_f32 v93, v93, v27
  v_cvt_pk_bf16_f32 v77, v92, v93
  v_lshlrev_b32 v92, 16, v54
  v_and_b32 v93, s58, v54
  v_mul_f32 v92, v92, v28
  v_mul_f32 v93, v93, v29
  v_cvt_pk_bf16_f32 v78, v92, v93
  v_lshlrev_b32 v92, 16, v55
  v_and_b32 v93, s58, v55
  v_mul_f32 v92, v92, v30
  v_mul_f32 v93, v93, v31
  v_cvt_pk_bf16_f32 v79, v92, v93
  s_waitcnt lgkmcnt(4)
  v_cvt_f32_i32 v32, v32
  v_cvt_f32_i32 v33, v33
  v_cvt_f32_i32 v34, v34
  v_cvt_f32_i32 v35, v35
  v_cvt_f32_i32 v36, v36
  v_cvt_f32_i32 v37, v37
  v_cvt_f32_i32 v38, v38
  v_cvt_f32_i32 v39, v39
  v_cvt_pk_bf16_f32 v64, v32, v33
  v_cvt_pk_bf16_f32 v65, v34, v35
  v_cvt_pk_bf16_f32 v66, v36, v37
  v_cvt_pk_bf16_f32 v67, v38, v39
  s_waitcnt lgkmcnt(2)
  v_cvt_f32_i32 v40, v40
  v_cvt_f32_i32 v41, v41
  v_cvt_f32_i32 v42, v42
  v_cvt_f32_i32 v43, v43
  v_cvt_f32_i32 v44, v44
  v_cvt_f32_i32 v45, v45
  v_cvt_f32_i32 v46, v46
  v_cvt_f32_i32 v47, v47
  v_cvt_pk_bf16_f32 v68, v40, v41
  v_cvt_pk_bf16_f32 v69, v42, v43
  v_cvt_pk_bf16_f32 v70, v44, v45
  v_cvt_pk_bf16_f32 v71, v46, v47
  s_waitcnt lgkmcnt(0)
  v_xor_b32 v56, 0x80008000, v56
  v_xor_b32 v57, 0x80008000, v57
  v_xor_b32 v58, 0x80008000, v58
  v_xor_b32 v59, 0x80008000, v59
  v_mfma_f32_16x16x32_bf16 v[80:83], v[64:67], v[72:75], 0
  v_xor_b32 v60, 0x80008000, v60
  v_xor_b32 v61, 0x80008000, v61
  v_xor_b32 v62, 0x80008000, v62
  v_xor_b32 v63, 0x80008000, v63
  v_mfma_f32_16x16x32_bf16 v[80:83], v[68:71], v[76:79], v[80:83]
  v_mfma_f32_16x16x32_bf16 v[80:83], v[56:59], v[72:75], v[80:83]
  v_mfma_f32_16x16x32_bf16 v[80:83], v[60:63], v[76:79], v[80:83]
  s_nop 7
  v_permlane32_swap_b32 v80, v81
  v_permlane32_swap_b32 v82, v83
  s_nop 1
  v_add_f32_dpp v92, v81, v80 row_shl:4 row_mask:0xf bank_mask:0xf bound_ctrl:1
  v_add_f32_dpp v93, v83, v82 row_shl:4 row_mask:0xf bank_mask:0xf bound_ctrl:1
  s_mov_b64 exec, s[48:49]
  ds_write_b32 v10, v92 offset:1024
  ds_write_b32 v10, v93 offset:1032
  v_max3_f32 v11, v11, v92, v93
  s_mov_b64 exec, -1
  s_waitcnt vmcnt(0)
  s_barrier
  ds_read_b128 v[48:51], v8 offset:768
  ds_read_b128 v[52:55], v8 offset:832
  ds_read_b128 v[32:35], v4 offset:49152
  ds_read_b128 v[36:39], v5 offset:49152
  ds_read_b128 v[40:43], v6 offset:49152
  ds_read_b128 v[44:47], v7 offset:49152
  ds_read_b128 v[56:59], v9 offset:768
  ds_read_b128 v[60:63], v9 offset:832
  s_waitcnt lgkmcnt(7)
  v_lshlrev_b32 v92, 16, v48
  v_and_b32 v93, s58, v48
  v_mul_f32 v92, v92, v16
  v_mul_f32 v93, v93, v17
  v_cvt_pk_bf16_f32 v72, v92, v93
  v_lshlrev_b32 v92, 16, v49
  v_and_b32 v93, s58, v49
  v_mul_f32 v92, v92, v18
  v_mul_f32 v93, v93, v19
  v_cvt_pk_bf16_f32 v73, v92, v93
  v_lshlrev_b32 v92, 16, v50
  v_and_b32 v93, s58, v50
  v_mul_f32 v92, v92, v20
  v_mul_f32 v93, v93, v21
  v_cvt_pk_bf16_f32 v74, v92, v93
  v_lshlrev_b32 v92, 16, v51
  v_and_b32 v93, s58, v51
  v_mul_f32 v92, v92, v22
  v_mul_f32 v93, v93, v23
  v_cvt_pk_bf16_f32 v75, v92, v93
  s_waitcnt lgkmcnt(6)
  v_lshlrev_b32 v92, 16, v52
  v_and_b32 v93, s58, v52
  v_mul_f32 v92, v92, v24
  v_mul_f32 v93, v93, v25
  v_cvt_pk_bf16_f32 v76, v92, v93
  v_lshlrev_b32 v92, 16, v53
  v_and_b32 v93, s58, v53
  v_mul_f32 v92, v92, v26
  v_mul_f32 v93, v93, v27
  v_cvt_pk_bf16_f32 v77, v92, v93
  v_lshlrev_b32 v92, 16, v54
  v_and_b32 v93, s58, v54
  v_mul_f32 v92, v92, v28
  v_mul_f32 v93, v93, v29
  v_cvt_pk_bf16_f32 v78, v92, v93
  v_lshlrev_b32 v92, 16, v55
  v_and_b32 v93, s58, v55
  v_mul_f32 v92, v92, v30
  v_mul_f32 v93, v93, v31
  v_cvt_pk_bf16_f32 v79, v92, v93
  s_waitcnt lgkmcnt(4)
  v_cvt_f32_i32 v32, v32
  v_cvt_f32_i32 v33, v33
  v_cvt_f32_i32 v34, v34
  v_cvt_f32_i32 v35, v35
  v_cvt_f32_i32 v36, v36
  v_cvt_f32_i32 v37, v37
  v_cvt_f32_i32 v38, v38
  v_cvt_f32_i32 v39, v39
  v_cvt_pk_bf16_f32 v64, v32, v33
  v_cvt_pk_bf16_f32 v65, v34, v35
  v_cvt_pk_bf16_f32 v66, v36, v37
  v_cvt_pk_bf16_f32 v67, v38, v39
  s_waitcnt lgkmcnt(2)
  v_cvt_f32_i32 v40, v40
  v_cvt_f32_i32 v41, v41
  v_cvt_f32_i32 v42, v42
  v_cvt_f32_i32 v43, v43
  v_cvt_f32_i32 v44, v44
  v_cvt_f32_i32 v45, v45
  v_cvt_f32_i32 v46, v46
  v_cvt_f32_i32 v47, v47
  v_cvt_pk_bf16_f32 v68, v40, v41
  v_cvt_pk_bf16_f32 v69, v42, v43
  v_cvt_pk_bf16_f32 v70, v44, v45
  v_cvt_pk_bf16_f32 v71, v46, v47
  s_waitcnt lgkmcnt(0)
  v_xor_b32 v56, 0x80008000, v56
  v_xor_b32 v57, 0x80008000, v57
  v_xor_b32 v58, 0x80008000, v58
  v_xor_b32 v59, 0x80008000, v59
  v_mfma_f32_16x16x32_bf16 v[80:83], v[64:67], v[72:75], 0
  v_xor_b32 v60, 0x80008000, v60
  v_xor_b32 v61, 0x80008000, v61
  v_xor_b32 v62, 0x80008000, v62
  v_xor_b32 v63, 0x80008000, v63
  v_mfma_f32_16x16x32_bf16 v[80:83], v[68:71], v[76:79], v[80:83]
  v_mfma_f32_16x16x32_bf16 v[80:83], v[56:59], v[72:75], v[80:83]
  v_mfma_f32_16x16x32_bf16 v[80:83], v[60:63], v[76:79], v[80:83]
  s_nop 7
  v_permlane32_swap_b32 v80, v81
  v_permlane32_swap_b32 v82, v83
  s_nop 1
  v_add_f32_dpp v92, v81, v80 row_shl:4 row_mask:0xf bank_mask:0xf bound_ctrl:1
  v_add_f32_dpp v93, v83, v82 row_shl:4 row_mask:0xf bank_mask:0xf bound_ctrl:1
  s_mov_b64 exec, s[48:49]
  ds_write_b32 v10, v92 offset:1536
  ds_write_b32 v10, v93 offset:1544
  v_max3_f32 v11, v11, v92, v93
  s_mov_b64 exec, -1
  v_add_u32 v8, 0x400, v8
  v_add_u32 v9, 0x400, v9
  v_add_u32 v10, 0x800, v10
  s_cmp_eq_u32 s59, s55
  s_cbranch_scc1 L_khook
L_kn:
  s_add_u32 s59, s59, 1
  s_cmp_lt_u32 s59, 15
  s_cbranch_scc1 L_k
  v_mov_b32 v72, -1
  v_mov_b32 v73, -1
  buffer_store_dwordx2 v[72:73], v104, s[44:47], s57 offen sc1
  s_mov_b32 exec_lo, 0x00010001
  s_mov_b32 exec_hi, 0x00010001
  buffer_store_dwordx2 v[72:73], v105, s[44:47], s68 offen sc1
  s_mov_b64 exec, -1
  ds_read_b32 v96, v99 offset:32
  s_mov_b32 s59, 60
  s_waitcnt lgkmcnt(0)
  v_readfirstlane_b32 s61, v96
L_kx:
  s_cmp_lt_u32 s61, s59
  s_cbranch_scc1 L_kdone
  s_and_b32 s53, s59, 3
  s_lshl_b32 s53, s53, 14
  v_add_u32 v106, s53, v4
  v_add_u32 v107, s53, v5
  v_add_u32 v108, s53, v6
  v_add_u32 v109, s53, v7
  s_and_b32 s53, s59, 7
  s_mul_i32 s53, s53, 1280
  s_add_u32 s53, s53, 139264
  v_add_u32 v10, s53, v112
  s_add_u32 s54, s53, 640
  v_add_u32 v8, s54, v110
  s_add_u32 s54, s53, 896
  v_add_u32 v9, s54, v111
  s_barrier
  s_sub_u32 s53, s59, 2
  s_and_b32 s54, s53, 3
  s_cmp_lg_u32 s54, s3
  s_cbranch_scc1 L_kxp
  s_cmp_lt_u32 s53, 60
  s_cbranch_scc1 L_kxp
  s_and_b32 s53, s53, 7
  s_lshl2_add_u32 s54, s53, 149824
  s_mul_i32 s53, s53, 1280
  s_add_u32 s53, s53, 139264
  v_mov_b32 v95, s54
  v_add_u32 v94, s53, v3
  s_mov_b32 exec_hi, 0xff
  ds_read_b32 v95, v95
  ds_read_b128 v[64:67], v94
  s_mul_i32 s54, s50, 64
  s_waitcnt lgkmcnt(0)
  v_readfirstlane_b32 s53, v95
  s_add_u32 s53, s53, s54
  s_mul_i32 s53, s53, 640
  s_add_u32 s53, s53, 720896
  buffer_store_dwordx4 v[64:67], v3, s[44:47], s53 offen sc1
  s_mov_b64 exec, -1
L_kxp:
  ds_read_b128 v[48:51], v8 offset:0
  ds_read_b128 v[52:55], v8 offset:64
  ds_read_b128 v[32:35], v106 offset:0
  ds_read_b128 v[36:39], v107 offset:0
  ds_read_b128 v[40:43], v108 offset:0
  ds_read_b128 v[44:47], v109 offset:0
  ds_read_b128 v[56:59], v9 offset:0
  ds_read_b128 v[60:63], v9 offset:64
  ds_read_b32 v96, v99 offset:32
  s_waitcnt lgkmcnt(8)
  v_lshlrev_b32 v92, 16, v48
  v_and_b32 v93, s58, v48
  v_mul_f32 v92, v92, v16
  v_mul_f32 v93, v93, v17
  v_cvt_pk_bf16_f32 v72, v92, v93
  v_lshlrev_b32 v92, 16, v49
  v_and_b32 v93, s58, v49
  v_mul_f32 v92, v92, v18
  v_mul_f32 v93, v93, v19
  v_cvt_pk_bf16_f32 v73, v92, v93
  v_lshlrev_b32 v92, 16, v50
  v_and_b32 v93, s58, v50
  v_mul_f32 v92, v92, v20
  v_mul_f32 v93, v93, v21
  v_cvt_pk_bf16_f32 v74, v92, v93
  v_lshlrev_b32 v92, 16, v51
  v_and_b32 v93, s58, v51
  v_mul_f32 v92, v92, v22
  v_mul_f32 v93, v93, v23
  v_cvt_pk_bf16_f32 v75, v92, v93
  s_waitcnt lgkmcnt(7)
  v_lshlrev_b32 v92, 16, v52
  v_and_b32 v93, s58, v52
  v_mul_f32 v92, v92, v24
  v_mul_f32 v93, v93, v25
  v_cvt_pk_bf16_f32 v76, v92, v93
  v_lshlrev_b32 v92, 16, v53
  v_and_b32 v93, s58, v53
  v_mul_f32 v92, v92, v26
  v_mul_f32 v93, v93, v27
  v_cvt_pk_bf16_f32 v77, v92, v93
  v_lshlrev_b32 v92, 16, v54
  v_and_b32 v93, s58, v54
  v_mul_f32 v92, v92, v28
  v_mul_f32 v93, v93, v29
  v_cvt_pk_bf16_f32 v78, v92, v93
  v_lshlrev_b32 v92, 16, v55
  v_and_b32 v93, s58, v55
  v_mul_f32 v92, v92, v30
  v_mul_f32 v93, v93, v31
  v_cvt_pk_bf16_f32 v79, v92, v93
  s_waitcnt lgkmcnt(5)
  v_cvt_f32_i32 v32, v32
  v_cvt_f32_i32 v33, v33
  v_cvt_f32_i32 v34, v34
  v_cvt_f32_i32 v35, v35
  v_cvt_f32_i32 v36, v36
  v_cvt_f32_i32 v37, v37
  v_cvt_f32_i32 v38, v38
  v_cvt_f32_i32 v39, v39
  v_cvt_pk_bf16_f32 v64, v32, v33
  v_cvt_pk_bf16_f32 v65, v34, v35
  v_cvt_pk_bf16_f32 v66, v36, v37
  v_cvt_pk_bf16_f32 v67, v38, v39
  s_waitcnt lgkmcnt(3)
  v_cvt_f32_i32 v40, v40
  v_cvt_f32_i32 v41, v41
  v_cvt_f32_i32 v42, v42
  v_cvt_f32_i32 v43, v43
  v_cvt_f32_i32 v44, v44
  v_cvt_f32_i32 v45, v45
  v_cvt_f32_i32 v46, v46
  v_cvt_f32_i32 v47, v47
  v_cvt_pk_bf16_f32 v68, v40, v41
  v_cvt_pk_bf16_f32 v69, v42, v43
  v_cvt_pk_bf16_f32 v70, v44, v45
  v_cvt_pk_bf16_f32 v71, v46, v47
  s_waitcnt lgkmcnt(0)
  v_xor_b32 v56, 0x80008000, v56
  v_xor_b32 v57, 0x80008000, v57
  v_xor_b32 v58, 0x80008000, v58
  v_xor_b32 v59, 0x80008000, v59
  v_mfma_f32_16x16x32_bf16 v[80:83], v[64:67], v[72:75], 0
  v_xor_b32 v60, 0x80008000, v60
  v_xor_b32 v61, 0x80008000, v61
  v_xor_b32 v62, 0x80008000, v62
  v_xor_b32 v63, 0x80008000, v63
  v_mfma_f32_16x16x32_bf16 v[80:83], v[68:71], v[76:79], v[80:83]
  v_mfma_f32_16x16x32_bf16 v[80:83], v[56:59], v[72:75], v[80:83]
  v_mfma_f32_16x16x32_bf16 v[80:83], v[60:63], v[76:79], v[80:83]
  v_readfirstlane_b32 s61, v96
  s_nop 6
  v_permlane32_swap_b32 v80, v81
  v_permlane32_swap_b32 v82, v83
  s_nop 1
  v_add_f32_dpp v92, v81, v80 row_shl:4 row_mask:0xf bank_mask:0xf bound_ctrl:1
  v_add_f32_dpp v93, v83, v82 row_shl:4 row_mask:0xf bank_mask:0xf bound_ctrl:1
  s_mov_b64 exec, s[48:49]
  ds_write_b32 v10, v92 offset:0
  ds_write_b32 v10, v93 offset:8
  s_mov_b64 exec, -1
  s_add_u32 s59, s59, 1
  s_branch L_kx
L_khook:
  s_lshl_b32 s53, s50, 4
  v_mov_b32 v94, s53
  v_mov_b32 v95, 1
  s_mov_b64 exec, 1
  s_cmp_lg_u32 s59, 1
  s_cbranch_scc1 L_kh1
  s_mov_b32 s55, s71
  global_store_dword v94, v95, s[20:21] sc1
  s_branch L_khx
L_kh1:
  s_cmp_lg_u32 s59, s71
  s_cbranch_scc1 L_kh2
  global_load_dword v98, v94, s[20:21] sc1
  s_add_u32 s55, s71, 1
  s_branch L_khx
L_kh2:
  s_cmp_eq_u32 s51, 0
  s_cselect_b32 s53, 1, 0
  v_or_b32 v95, s53, v98
  ds_write_b32 v99, v95 offset:48
  v_readfirstlane_b32 s64, v95
L_khx:
  s_mov_b64 exec, -1
  s_branch L_kn
L_kdone:
  v_and_b32 v92, 3, v1
  v_lshlrev_b32 v93, 2, v2
  v_lshl_add_u32 v92, v92, 6, v93
  s_lshl_b32 s53, s3, 4
  s_add_u32 s53, s53, 149504
  v_add_u32 v92, s53, v92
  s_mov_b64 exec, s[48:49]
  ds_write_b32 v92, v11
  s_mov_b64 exec, -1
  v_lshrrev_b32 v93, 2, v1
  v_lshlrev_b32 v93, 6, v93
  v_add_u32 v93, 149504, v93
  v_mov_b32 v80, 0
  v_mov_b32 v81, 0
  v_mov_b32 v82, 0
  v_mov_b32 v83, 0
  v_mov_b32 v84, 0
  v_mov_b32 v85, 0
  v_mov_b32 v86, 0
  v_mov_b32 v87, 0
  v_mov_b32 v88, 0
  v_mov_b32 v89, 0
  v_mov_b32 v90, 0
  v_mov_b32 v91, 0
  s_mov_b32 s60, s59
  s_add_u32 s61, s59, 60
  s_add_u32 s55, s59, 1
  s_mov_b32 s62, 0
  s_and_b32 s53, s59, 3
  s_lshl_b32 s53, s53, 14
  v_add_u32 v12, s53, v12
  s_waitcnt lgkmcnt(0)
  s_barrier
  ds_read_b128 v[32:35], v93 offset:0
  ds_read_b128 v[36:39], v93 offset:16
  ds_read_b128 v[40:43], v93 offset:32
  ds_read_b128 v[44:47], v93 offset:48
  s_waitcnt lgkmcnt(0)
  v_max3_f32 v11, v32, v33, v34
  v_max3_f32 v11, v11, v35, v36
  v_max3_f32 v11, v11, v37, v38
  v_max3_f32 v11, v11, v39, v40
  v_max3_f32 v11, v11, v41, v42
  v_max3_f32 v11, v11, v43, v44
  v_max3_f32 v11, v11, v45, v46
  v_max_f32 v11, v11, v47
  s_branch L_v0
L_hook:
  s_add_u32 s62, s62, 1
  s_cmp_lg_u32 s62, 1
  s_cbranch_scc1 L_h1
  s_sub_u32 s53, s60, 1
  s_sub_u32 s54, s53, s3
  s_and_b32 s54, s54, 3
  s_sub_u32 s53, s53, s54
  s_cmp_ge_u32 s54, 2
  s_cbranch_scc1 L_hp
  s_and_b32 s54, s53, 3
  s_cmp_lg_u32 s54, s3
  s_cbranch_scc1 L_hp
  s_cmp_lt_u32 s53, 60
  s_cbranch_scc1 L_hp
  s_and_b32 s53, s53, 7
  s_lshl2_add_u32 s54, s53, 149824
  s_mul_i32 s53, s53, 1280
  s_add_u32 s53, s53, 139264
  v_mov_b32 v95, s54
  v_add_u32 v94, s53, v3
  s_mov_b32 exec_hi, 0xff
  ds_read_b32 v95, v95
  ds_read_b128 v[56:59], v94
  s_mul_i32 s54, s50, 64
  s_waitcnt lgkmcnt(0)
  v_readfirstlane_b32 s53, v95
  s_add_u32 s53, s53, s54
  s_mul_i32 s53, s53, 640
  s_add_u32 s53, s53, 720896
  buffer_store_dwordx4 v[56:59], v3, s[44:47], s53 offen sc1
  s_mov_b64 exec, -1
L_hp:
  s_add_u32 s55, s55, 2
  s_branch L_v1
L_h1:
  s_cmp_lg_u32 s62, 2
  s_cbranch_scc1 L_h2
  s_waitcnt vmcnt(0)
  s_add_u32 s55, s55, 1
  s_cmp_eq_u32 s3, 0
  s_cselect_b32 s55, s55, 0
  s_branch L_v1
L_h2:
  s_mov_b64 exec, 1
  s_cmp_lg_u32 s62, 3
  s_cbranch_scc1 L_h3
  s_cmp_lg_u32 s64, 0
  s_cbranch_scc1 L_h2a
  s_mov_b32 s55, 1048576
  s_lshl_b32 s53, s50, 4
  v_mov_b32 v94, s53
L_h2w:
  global_load_dword v98, v94, s[20:21] sc1
  s_sub_u32 s55, s55, 1
  s_waitcnt vmcnt(0)
  s_cbranch_scc1 L_h2a
  v_readfirstlane_b32 s64, v98
  s_cmp_eq_u32 s64, 0
  s_cbranch_scc1 L_h2w
L_h2a:
  s_mul_i32 s53, s50, 4096
  s_add_u32 s53, s53, 590848
  v_mov_b32 v94, s53
  v_mov_b32 v93, 1
  global_atomic_add v97, v94, v93, s[22:23] sc0 sc1
  s_add_u32 s55, s60, 36
  s_branch L_hx
L_h3:
  s_waitcnt vmcnt(0)
  s_cmp_lg_u32 s62, 4
  s_cbranch_scc1 L_h4
  s_mul_i32 s53, s50, 4096
  s_add_u32 s53, s53, 590848
  v_mov_b32 v94, s53
  global_load_dword v98, v94, s[22:23] sc1
  s_add_u32 s55, s55, 3
  s_branch L_hx
L_h4:
  v_add_u32 v97, 1, v97
  v_max_u32 v92, v97, v98
  v_lshrrev_b32 v92, 4, v92
  ds_write_b32 v99, v92 offset:16
L_hx:
  s_mov_b64 exec, -1
  s_branch L_v1
L_v0:
  ds_read_b128 v[16:19], v13
  ds_read_b128 v[20:23], v13 offset:16
  ds_read_b128 v[24:27], v14 offset:0
  ds_read_b128 v[28:31], v14 offset:4096
  v_add_u32 v13, 0x200, v13
  v_add_u32 v14, 64, v14
  s_waitcnt lgkmcnt(2)
  v_sub_f32 v16, v16, v11
  v_sub_f32 v17, v17, v11
  v_sub_f32 v18, v18, v11
  v_sub_f32 v19, v19, v11
  v_sub_f32 v20, v20, v11
  v_sub_f32 v21, v21, v11
  v_sub_f32 v22, v22, v11
  v_sub_f32 v23, v23, v11
  v_exp_f32 v16, v16
  v_exp_f32 v17, v17
  v_exp_f32 v18, v18
  v_exp_f32 v19, v19
  v_exp_f32 v20, v20
  v_exp_f32 v21, v21
  v_exp_f32 v22, v22
  v_exp_f32 v23, v23
  s_waitcnt lgkmcnt(1)
  v_lshlrev_b32 v48, 16, v24
  v_and_b32 v49, s58, v24
  v_lshlrev_b32 v50, 16, v25
  v_and_b32 v51, s58, v25
  v_lshlrev_b32 v52, 16, v26
  v_and_b32 v53, s58, v26
  v_lshlrev_b32 v54, 16, v27
  v_and_b32 v55, s58, v27
  v_mul_f32 v48, v48, v16
  v_mul_f32 v49, v49, v17
  v_mul_f32 v50, v50, v18
  v_mul_f32 v51, v51, v19
  v_mul_f32 v52, v52, v20
  v_mul_f32 v53, v53, v21
  v_mul_f32 v54, v54, v22
  v_mul_f32 v55, v55, v23
  v_cvt_pk_bf16_f32 v64, v48, v49
  v_cvt_pk_bf16_f32 v65, v50, v51
  v_cvt_pk_bf16_f32 v66, v52, v53
  v_cvt_pk_bf16_f32 v67, v54, v55
  v_add_f32 v15, v15, v16
  v_add_f32 v15, v15, v17
  v_add_f32 v15, v15, v18
  v_add_f32 v15, v15, v19
  v_add_f32 v15, v15, v20
  v_add_f32 v15, v15, v21
  v_add_f32 v15, v15, v22
  v_add_f32 v15, v15, v23
  s_waitcnt lgkmcnt(0)
  v_mfma_f32_16x16x32_bf16 v[88:91], v[64:67], v[28:31], v[88:91]
  s_cmp_eq_u32 s59, s60
  s_cbranch_scc1 L_v1
  s_barrier
  s_cmp_eq_u32 s59, s55
  s_cbranch_scc1 L_hook
L_v1:
  ds_read_b64 v[32:33], v12 offset:0
  ds_read_b64 v[34:35], v12 offset:512
  ds_read_b64 v[36:37], v12 offset:1024
  ds_read_b64 v[38:39], v12 offset:1536
  ds_read_b64 v[40:41], v12 offset:2048
  ds_read_b64 v[42:43], v12 offset:2560
  ds_read_b64 v[44:45], v12 offset:3072
  ds_read_b64 v[46:47], v12 offset:3584
  ds_read_b32 v96, v99 offset:0
  v_add_u32 v12, 0x4000, v12
  v_and_b32 v12, 0xffff, v12
  s_waitcnt lgkmcnt(7)
  v_cvt_f32_i32 v32, v32
  v_cvt_f32_i32 v33, v33
  v_cvt_f32_i32 v34, v34
  v_cvt_f32_i32 v35, v35
  v_cvt_pk_bf16_f32 v72, v32, v34
  v_cvt_pk_bf16_f32 v76, v33, v35
  s_waitcnt lgkmcnt(5)
  v_cvt_f32_i32 v36, v36
  v_cvt_f32_i32 v37, v37
  v_cvt_f32_i32 v38, v38
  v_cvt_f32_i32 v39, v39
  v_cvt_pk_bf16_f32 v73, v36, v38
  v_cvt_pk_bf16_f32 v77, v37, v39
  s_waitcnt lgkmcnt(3)
  v_cvt_f32_i32 v40, v40
  v_cvt_f32_i32 v41, v41
  v_cvt_f32_i32 v42, v42
  v_cvt_f32_i32 v43, v43
  v_cvt_pk_bf16_f32 v74, v40, v42
  v_cvt_pk_bf16_f32 v78, v41, v43
  s_waitcnt lgkmcnt(0)
  v_cvt_f32_i32 v44, v44
  v_cvt_f32_i32 v45, v45
  v_cvt_f32_i32 v46, v46
  v_cvt_f32_i32 v47, v47
  v_cvt_pk_bf16_f32 v75, v44, v46
  v_cvt_pk_bf16_f32 v79, v45, v47
  v_readfirstlane_b32 s53, v96
  v_mfma_f32_16x16x32_bf16 v[80:83], v[64:67], v[72:75], v[80:83]
  v_mfma_f32_16x16x32_bf16 v[84:87], v[64:67], v[76:79], v[84:87]
  s_add_u32 s59, s59, 1
  s_cmp_lt_u32 s59, s61
  s_cbranch_scc1 L_v0
  s_cmp_lt_u32 s53, s59
  s_cbranch_scc1 L_vend
  v_subrev_u32 v8, -40960, v13
  v_subrev_u32 v9, -4096, v14
  s_and_b32 s54, s59, 3
  s_lshl_b32 s54, s54, 10
  v_add_u32 v13, s54, v8
  v_add_u32 v14, s54, v9
  ds_read_b128 v[16:19], v13
  ds_read_b128 v[20:23], v13 offset:16
  ds_read_b128 v[24:27], v14 offset:512
  ds_read_b128 v[28:31], v14 offset:576
L_vy:
  s_waitcnt lgkmcnt(2)
  v_max3_f32 v92, v16, v17, v18
  v_max3_f32 v92, v92, v19, v20
  v_max3_f32 v92, v92, v21, v22
  v_max3_f32 v92, v92, v23, v11
  v_mov_b32 v93, v92
  s_nop 1
  v_permlane32_swap_b32 v92, v93
  s_nop 0
  v_max_f32 v92, v92, v93
  v_mov_b32 v93, v92
  s_nop 1
  v_permlane16_swap_b32 v92, v93
  s_nop 0
  v_max_f32 v92, v92, v93
  v_sub_f32 v93, v11, v92
  v_exp_f32 v93, v93
  v_mov_b32 v11, v92
  v_sub_f32 v16, v16, v11
  v_sub_f32 v17, v17, v11
  v_sub_f32 v18, v18, v11
  v_sub_f32 v19, v19, v11
  v_sub_f32 v20, v20, v11
  v_sub_f32 v21, v21, v11
  v_sub_f32 v22, v22, v11
  v_sub_f32 v23, v23, v11
  v_mul_f32 v15, v15, v93
  v_mov_b32_dpp v94, v93 row_newbcast:0 row_mask:0x1 bank_mask:0xf
  v_mov_b32_dpp v94, v93 row_newbcast:4 row_mask:0x2 bank_mask:0xf
  v_mov_b32_dpp v94, v93 row_newbcast:8 row_mask:0x4 bank_mask:0xf
  v_mov_b32_dpp v94, v93 row_newbcast:12 row_mask:0x8 bank_mask:0xf
  v_exp_f32 v16, v16
  v_exp_f32 v17, v17
  v_exp_f32 v18, v18
  v_exp_f32 v19, v19
  v_exp_f32 v20, v20
  v_exp_f32 v21, v21
  v_exp_f32 v22, v22
  v_exp_f32 v23, v23
  v_mul_f32 v80, v80, v94
  v_mul_f32 v84, v84, v94
  v_mul_f32 v88, v88, v94
  s_waitcnt lgkmcnt(1)
  v_lshlrev_b32 v48, 16, v24
  v_and_b32 v49, s58, v24
  v_lshlrev_b32 v50, 16, v25
  v_and_b32 v51, s58, v25
  v_lshlrev_b32 v52, 16, v26
  v_and_b32 v53, s58, v26
  v_lshlrev_b32 v54, 16, v27
  v_and_b32 v55, s58, v27
  v_mul_f32 v48, v48, v16
  v_mul_f32 v49, v49, v17
  v_mul_f32 v50, v50, v18
  v_mul_f32 v51, v51, v19
  v_mul_f32 v52, v52, v20
  v_mul_f32 v53, v53, v21
  v_mul_f32 v54, v54, v22
  v_mul_f32 v55, v55, v23
  v_cvt_pk_bf16_f32 v64, v48, v49
  v_cvt_pk_bf16_f32 v65, v50, v51
  v_cvt_pk_bf16_f32 v66, v52, v53
  v_cvt_pk_bf16_f32 v67, v54, v55
  v_add_f32 v15, v15, v16
  v_add_f32 v15, v15, v17
  v_add_f32 v15, v15, v18
  v_add_f32 v15, v15, v19
  v_add_f32 v15, v15, v20
  v_add_f32 v15, v15, v21
  v_add_f32 v15, v15, v22
  v_add_f32 v15, v15, v23
  s_waitcnt lgkmcnt(0)
  v_mfma_f32_16x16x32_bf16 v[88:91], v[64:67], v[28:31], v[88:91]
  s_add_u32 s59, s59, 1
  s_and_b32 s54, s59, 3
  s_lshl_b32 s54, s54, 10
  v_add_u32 v13, s54, v8
  v_add_u32 v14, s54, v9
  s_barrier
  ds_read_b64 v[32:33], v12 offset:0
  ds_read_b64 v[34:35], v12 offset:512
  ds_read_b64 v[36:37], v12 offset:1024
  ds_read_b64 v[38:39], v12 offset:1536
  ds_read_b64 v[40:41], v12 offset:2048
  ds_read_b64 v[42:43], v12 offset:2560
  ds_read_b64 v[44:45], v12 offset:3072
  ds_read_b64 v[46:47], v12 offset:3584
  ds_read_b32 v96, v99 offset:0
  ds_read_b128 v[16:19], v13
  ds_read_b128 v[20:23], v13 offset:16
  ds_read_b128 v[24:27], v14 offset:512
  ds_read_b128 v[28:31], v14 offset:576
  v_add_u32 v12, 0x4000, v12
  v_and_b32 v12, 0xffff, v12
  s_waitcnt lgkmcnt(11)
  v_cvt_f32_i32 v32, v32
  v_cvt_f32_i32 v33, v33
  v_cvt_f32_i32 v34, v34
  v_cvt_f32_i32 v35, v35
  v_cvt_pk_bf16_f32 v72, v32, v34
  v_cvt_pk_bf16_f32 v76, v33, v35
  s_waitcnt lgkmcnt(9)
  v_cvt_f32_i32 v36, v36
  v_cvt_f32_i32 v37, v37
  v_cvt_f32_i32 v38, v38
  v_cvt_f32_i32 v39, v39
  v_cvt_pk_bf16_f32 v73, v36, v38
  v_cvt_pk_bf16_f32 v77, v37, v39
  s_waitcnt lgkmcnt(7)
  v_cvt_f32_i32 v40, v40
  v_cvt_f32_i32 v41, v41
  v_cvt_f32_i32 v42, v42
  v_cvt_f32_i32 v43, v43
  v_cvt_pk_bf16_f32 v74, v40, v42
  v_cvt_pk_bf16_f32 v78, v41, v43
  s_waitcnt lgkmcnt(4)
  v_cvt_f32_i32 v44, v44
  v_cvt_f32_i32 v45, v45
  v_cvt_f32_i32 v46, v46
  v_cvt_f32_i32 v47, v47
  v_cvt_pk_bf16_f32 v75, v44, v46
  v_cvt_pk_bf16_f32 v79, v45, v47
  v_readfirstlane_b32 s53, v96
  v_mfma_f32_16x16x32_bf16 v[80:83], v[64:67], v[72:75], v[80:83]
  v_mfma_f32_16x16x32_bf16 v[84:87], v[64:67], v[76:79], v[84:87]
  s_cmp_ge_u32 s53, s59
  s_cbranch_scc1 L_vy
  s_waitcnt lgkmcnt(0)
L_vend:
  v_mov_b32 v92, v15
  ds_read_b32 v95, v99 offset:16
  s_lshl_b32 s54, s3, 2
  v_permlane32_swap_b32 v92, v15
  v_min_u32 v11, -2, v11
  v_add_f32 v15, v92, v15
  v_mov_b32 v92, v15
  v_mov_b32_dpp v18, v11 row_newbcast:0 row_mask:0x1 bank_mask:0xf
  v_mov_b32_dpp v18, v11 row_newbcast:4 row_mask:0x2 bank_mask:0xf
  v_permlane16_swap_b32 v92, v15
  v_mov_b32_dpp v18, v11 row_newbcast:8 row_mask:0x4 bank_mask:0xf
  v_add_f32 v15, v92, v15
  v_mov_b32_dpp v18, v11 row_newbcast:12 row_mask:0x8 bank_mask:0xf
  v_min_u32 v15, -2, v15
  v_sub_f32 v16, v80, v88
  v_sub_f32 v17, v84, v88
  v_mov_b32_dpp v19, v15 row_newbcast:0 row_mask:0x1 bank_mask:0xf
  v_min_u32 v16, -2, v16
  v_min_u32 v17, -2, v17
  buffer_store_dwordx2 v[16:17], v104, s[44:47], s57 offen sc1
  v_mov_b32_dpp v19, v15 row_newbcast:4 row_mask:0x2 bank_mask:0xf
  v_mov_b32_dpp v19, v15 row_newbcast:8 row_mask:0x4 bank_mask:0xf
  v_mov_b32_dpp v19, v15 row_newbcast:12 row_mask:0x8 bank_mask:0xf
  s_mov_b32 exec_lo, 0x00010001
  s_mov_b32 exec_hi, 0x00010001
  buffer_store_dwordx2 v[18:19], v105, s[44:47], s68 offen sc1
  s_mov_b64 exec, -1
  s_and_b32 s53, s50, 3
  s_add_u32 s54, s54, s53
  s_cmp_lg_u32 s54, s51
  s_cbranch_scc1 L_fin
  v_add_u32 v4, 0x1000, v104
  v_lshl_add_u32 v5, v1, 5, v105
  s_mov_b32 s28, s18
  s_mov_b32 s29, s19
  s_mov_b32 s30, 0x4000
  s_mov_b32 s31, 0x20000
  v_lshlrev_b32 v8, 2, v1
  v_lshl_add_u32 v8, v2, 8, v8
  s_lshl_b32 s57, s3, 6
  s_add_u32 s57, s57, s52
  s_mov_b32 s55, 1048576
  s_waitcnt lgkmcnt(0)
  v_readfirstlane_b32 s53, v95
  s_cmp_lg_u32 s53, 0
  s_cbranch_scc1 L_poll
  s_mul_i32 s53, s50, 4096
  s_add_u32 s53, s53, 590848
  v_mov_b32 v94, s53
L_arr:
  global_load_dword v10, v94, s[22:23] sc1
  s_sub_u32 s55, s55, 1
  s_waitcnt vmcnt(0)
  s_cbranch_scc1 L_fin
  v_readfirstlane_b32 s53, v10
  s_cmp_lt_u32 s53, 16
  s_cbranch_scc1 L_arr
L_poll:
  buffer_load_dwordx2 v[16:17], v5, s[44:47], s63 offen sc1
  buffer_load_dwordx2 v[20:21], v104, s[44:47], s56 offen offset:0 sc1
  buffer_load_dwordx2 v[22:23], v104, s[44:47], s56 offen offset:512 sc1
  buffer_load_dwordx2 v[24:25], v104, s[44:47], s56 offen offset:1024 sc1
  buffer_load_dwordx2 v[26:27], v104, s[44:47], s56 offen offset:1536 sc1
  buffer_load_dwordx2 v[28:29], v104, s[44:47], s56 offen offset:2048 sc1
  buffer_load_dwordx2 v[30:31], v104, s[44:47], s56 offen offset:2560 sc1
  buffer_load_dwordx2 v[32:33], v104, s[44:47], s56 offen offset:3072 sc1
  buffer_load_dwordx2 v[34:35], v104, s[44:47], s56 offen offset:3584 sc1
  buffer_load_dwordx2 v[36:37], v4, s[44:47], s56 offen offset:0 sc1
  buffer_load_dwordx2 v[38:39], v4, s[44:47], s56 offen offset:512 sc1
  buffer_load_dwordx2 v[40:41], v4, s[44:47], s56 offen offset:1024 sc1
  buffer_load_dwordx2 v[42:43], v4, s[44:47], s56 offen offset:1536 sc1
  buffer_load_dwordx2 v[44:45], v4, s[44:47], s56 offen offset:2048 sc1
  buffer_load_dwordx2 v[46:47], v4, s[44:47], s56 offen offset:2560 sc1
  buffer_load_dwordx2 v[48:49], v4, s[44:47], s56 offen offset:3072 sc1
  buffer_load_dwordx2 v[50:51], v4, s[44:47], s56 offen offset:3584 sc1
  s_sub_u32 s55, s55, 1
  s_cbranch_scc1 L_fin
  s_waitcnt vmcnt(16)
  v_max_u32 v14, v16, v17
  v_cmp_eq_u32 vcc, -1, v14
  v_mov_b32 v9, v16
  s_nop 3
  s_cbranch_vccnz L_poll
  v_max_f32_dpp v9, v9, v9 row_ror:8 row_mask:0xf bank_mask:0xf
  s_nop 1
  v_max_f32_dpp v9, v9, v9 row_ror:4 row_mask:0xf bank_mask:0xf
  s_nop 1
  v_max_f32_dpp v9, v9, v9 row_ror:2 row_mask:0xf bank_mask:0xf
  s_nop 1
  v_max_f32_dpp v9, v9, v9 row_ror:1 row_mask:0xf bank_mask:0xf
  s_nop 1
  v_sub_f32 v10, v16, v9
  v_exp_f32 v10, v10
  s_waitcnt vmcnt(8)
  v_mul_f32 v11, v10, v17
  v_max3_u32 v9, v14, v20, v21
  v_mul_f32_dpp v12, v10, v20 row_newbcast:0 row_mask:0xf bank_mask:0xf
  v_mul_f32_dpp v13, v10, v21 row_newbcast:0 row_mask:0xf bank_mask:0xf
  v_add_f32_dpp v11, v11, v11 row_ror:8 row_mask:0xf bank_mask:0xf
  v_max3_u32 v9, v9, v22, v23
  v_fmac_f32_dpp v12, v10, v22 row_newbcast:1 row_mask:0xf bank_mask:0xf
  v_fmac_f32_dpp v13, v10, v23 row_newbcast:1 row_mask:0xf bank_mask:0xf
  v_add_f32_dpp v11, v11, v11 row_ror:4 row_mask:0xf bank_mask:0xf
  v_max3_u32 v9, v9, v24, v25
  v_fmac_f32_dpp v12, v10, v24 row_newbcast:2 row_mask:0xf bank_mask:0xf
  v_fmac_f32_dpp v13, v10, v25 row_newbcast:2 row_mask:0xf bank_mask:0xf
  v_add_f32_dpp v11, v11, v11 row_ror:2 row_mask:0xf bank_mask:0xf
  v_max3_u32 v9, v9, v26, v27
  v_fmac_f32_dpp v12, v10, v26 row_newbcast:3 row_mask:0xf bank_mask:0xf
  v_fmac_f32_dpp v13, v10, v27 row_newbcast:3 row_mask:0xf bank_mask:0xf
  v_add_f32_dpp v11, v11, v11 row_ror:1 row_mask:0xf bank_mask:0xf
  v_max3_u32 v9, v9, v28, v29
  v_fmac_f32_dpp v12, v10, v28 row_newbcast:4 row_mask:0xf bank_mask:0xf
  v_fmac_f32_dpp v13, v10, v29 row_newbcast:4 row_mask:0xf bank_mask:0xf
  v_rcp_f32 v11, v11
  v_max3_u32 v9, v9, v30, v31
  v_fmac_f32_dpp v12, v10, v30 row_newbcast:5 row_mask:0xf bank_mask:0xf
  v_fmac_f32_dpp v13, v10, v31 row_newbcast:5 row_mask:0xf bank_mask:0xf
  v_max3_u32 v9, v9, v32, v33
  v_fmac_f32_dpp v12, v10, v32 row_newbcast:6 row_mask:0xf bank_mask:0xf
  v_fmac_f32_dpp v13, v10, v33 row_newbcast:6 row_mask:0xf bank_mask:0xf
  v_max3_u32 v9, v9, v34, v35
  v_fmac_f32_dpp v12, v10, v34 row_newbcast:7 row_mask:0xf bank_mask:0xf
  v_fmac_f32_dpp v13, v10, v35 row_newbcast:7 row_mask:0xf bank_mask:0xf
  s_waitcnt vmcnt(0)
  v_max3_u32 v9, v9, v36, v37
  v_fmac_f32_dpp v12, v10, v36 row_newbcast:8 row_mask:0xf bank_mask:0xf
  v_fmac_f32_dpp v13, v10, v37 row_newbcast:8 row_mask:0xf bank_mask:0xf
  v_max3_u32 v9, v9, v38, v39
  v_fmac_f32_dpp v12, v10, v38 row_newbcast:9 row_mask:0xf bank_mask:0xf
  v_fmac_f32_dpp v13, v10, v39 row_newbcast:9 row_mask:0xf bank_mask:0xf
  v_max3_u32 v9, v9, v40, v41
  v_fmac_f32_dpp v12, v10, v40 row_newbcast:10 row_mask:0xf bank_mask:0xf
  v_fmac_f32_dpp v13, v10, v41 row_newbcast:10 row_mask:0xf bank_mask:0xf
  v_max3_u32 v9, v9, v42, v43
  v_fmac_f32_dpp v12, v10, v42 row_newbcast:11 row_mask:0xf bank_mask:0xf
  v_fmac_f32_dpp v13, v10, v43 row_newbcast:11 row_mask:0xf bank_mask:0xf
  v_max3_u32 v9, v9, v44, v45
  v_fmac_f32_dpp v12, v10, v44 row_newbcast:12 row_mask:0xf bank_mask:0xf
  v_fmac_f32_dpp v13, v10, v45 row_newbcast:12 row_mask:0xf bank_mask:0xf
  v_max3_u32 v9, v9, v46, v47
  v_fmac_f32_dpp v12, v10, v46 row_newbcast:13 row_mask:0xf bank_mask:0xf
  v_fmac_f32_dpp v13, v10, v47 row_newbcast:13 row_mask:0xf bank_mask:0xf
  v_max3_u32 v9, v9, v48, v49
  v_fmac_f32_dpp v12, v10, v48 row_newbcast:14 row_mask:0xf bank_mask:0xf
  v_fmac_f32_dpp v13, v10, v49 row_newbcast:14 row_mask:0xf bank_mask:0xf
  v_max3_u32 v9, v9, v50, v51
  v_cmp_eq_u32 vcc, -1, v9
  v_fmac_f32_dpp v12, v10, v50 row_newbcast:15 row_mask:0xf bank_mask:0xf
  v_fmac_f32_dpp v13, v10, v51 row_newbcast:15 row_mask:0xf bank_mask:0xf
  v_mul_f32 v12, v12, v11
  v_mul_f32 v13, v13, v11
  v_cvt_pk_bf16_f32 v12, v12, v13
  s_nop 0
  s_cbranch_vccnz L_poll
  buffer_store_dword v12, v8, s[28:31], s57 offen
L_fin:
L_end:
  s_endpgm
.section .rodata,"a"
.p2align 6
.amdhsa_kernel standalone__kv_cache_quant_int4_int2_kv_with_per_channel_or_per_token_scales__decode_kernel
  .amdhsa_next_free_vgpr 116
  .amdhsa_next_free_sgpr 72
  .amdhsa_accum_offset 116
  .amdhsa_group_segment_fixed_size 0
  .amdhsa_kernarg_size 80
  .amdhsa_user_sgpr_count 2
  .amdhsa_user_sgpr_kernarg_segment_ptr 1
  .amdhsa_system_sgpr_workgroup_id_x 1
  .amdhsa_float_denorm_mode_32 3
.end_amdhsa_kernel
```
